```python
import torch

def _softmax(x, axis=-1):
    return torch.softmax(x, dim=axis)
def _gelu(x):
    return torch.nn.functional.gelu(x, approximate="tanh")
def _silu(x):
    return torch.nn.functional.silu(x)
def _sigmoid(x):
    return torch.sigmoid(x)
def _layernorm(x, axis=-1, eps=1e-5):
    m = x.mean(dim=axis, keepdim=True)
    v = x.var(dim=axis, keepdim=True, unbiased=False)
    return (x - m) / torch.sqrt(v + eps)
def _scatter_add(tgt, idx, src, axis=0):
    return tgt.clone().index_add_(axis, idx, src)
def _segment_sum(src, seg, n):
    out = torch.zeros((n,) + src.shape[1:], dtype=src.dtype)
    return out.index_add_(0, seg, src)
def _pad(x, pw):
    flat = tuple(v for pair in reversed(pw) for v in pair)
    return torch.nn.functional.pad(x, flat)

kernel_name = 'interleave_layers__sliding_block_cached__dense_activation_gelu__decode'

def setup_inputs():

    _w = (lambda a: (lambda t: t.to(torch.bfloat16) if t.is_floating_point() else t)(torch.as_tensor(a)))
    def _A_setup():
        B, Sq, D = 1, 1, 512
        Hq, Hkv, Sk, Dh = 32, 8, 65536, 128
        assert Hq % Hkv == 0, (Hq, Hkv)
        return {
            "x": _w((lambda *s: torch.randn(*s, dtype=torch.bfloat16) * 0.05)(B, Sq, D)),
            "k_cache": _w((lambda *s: torch.randn(*s, dtype=torch.bfloat16) * 0.8)(B, Hkv, Sk, Dh)),
            "v_cache": _w((lambda *s: torch.randn(*s, dtype=torch.bfloat16) * 1.6)(B, Hkv, Sk, Dh)),
            "wq": _w((lambda *s: torch.randn(*s, dtype=torch.bfloat16) * 0.8)(D, Hq * Dh) * (D ** -0.5)),
            "wo": _w((lambda *s: torch.randn(*s, dtype=torch.bfloat16) * 1.6)(Hq * Dh, D) * ((Hq * Dh) ** -0.5)),
        }
    _A_in = _A_setup()

    def _B_setup():
        B, S, D, F = 1, 1, 512, 1792
        return {
            "x": _w((lambda *s: torch.randn(*s, dtype=torch.bfloat16) * 0.05)(B, S, D)),
            "w1": _w((lambda *s: torch.randn(*s, dtype=torch.bfloat16) * 1.6)(D, F) * (D ** -0.5)),
            "b1": _w((lambda *s: torch.randn(*s, dtype=torch.bfloat16) * 1.6)(F) * 0.01),
            "w2": _w((lambda *s: torch.randn(*s, dtype=torch.bfloat16) * 0.2)(F, D) * (F ** -0.5)),
            "b2": _w((lambda *s: torch.randn(*s, dtype=torch.bfloat16) * 0.2)(D) * 0.01),
        }
    _B_in = _B_setup()

    return {
        "A_x": _A_in["x"],
        "A_k_cache": _A_in["k_cache"],
        "A_v_cache": _A_in["v_cache"],
        "A_wq": _A_in["wq"],
        "A_wo": _A_in["wo"],
        "B_x": _B_in["x"],
        "B_w1": _B_in["w1"],
        "B_b1": _B_in["b1"],
        "B_w2": _B_in["w2"],
        "B_b2": _B_in["b2"],
    }

def reference(A_x, A_k_cache, A_v_cache, A_wq, A_wo, B_x, B_w1, B_b1, B_w2, B_b2):
    def _A_ref(x, k_cache, v_cache, wq, wo):
        B, Sq, D = x.shape
        Hq, Dh = 32, 128
        Hkv, Sk = k_cache.shape[1], k_cache.shape[2]
        W = min(4096, max(256, Sk // 4))
        rep = Hq // Hkv
        q = (lambda x, *d: x.permute(*d))((x @ wq).reshape(B, Sq, Hq, Dh), 0, 2, 1, 3)
        k = (lambda x, n, axis: torch.repeat_interleave(x, n, dim=axis))(k_cache[:, :, Sk - W:, :], rep, axis=1)
        v = (lambda x, n, axis: torch.repeat_interleave(x, n, dim=axis))(v_cache[:, :, Sk - W:, :], rep, axis=1)
        scores = torch.einsum("bhqd,bhkd->bhqk", q, k) * (Dh ** -0.5)
        p = _softmax(scores, axis=-1)
        o = torch.einsum("bhqk,bhkd->bhqd", p, v)
        return (lambda x, *d: x.permute(*d))(o, 0, 2, 1, 3).reshape(B, Sq, Hq * Dh) @ wo

    def _B_ref(x, w1, b1, w2, b2):
        h = torch.einsum("bsd,df->bsf", x, w1) + b1
        h = _gelu(h)
        return torch.einsum("bsf,fd->bsd", h, w2) + b2

    x = A_x
    x = x + _A_ref(_layernorm(x, axis=-1), A_k_cache, A_v_cache, A_wq, A_wo)
    x = x + _B_ref(_layernorm(x, axis=-1), B_w1, B_b1, B_w2, B_b2)
    x = x + _A_ref(_layernorm(x, axis=-1), A_k_cache, A_v_cache, A_wq, A_wo)
    x = x + _B_ref(_layernorm(x, axis=-1), B_w1, B_b1, B_w2, B_b2)
    return x
```

```asm
; @launch grid=(256,1,1) block=(320,1,1) lds=37632
.amdgcn_target "amdgcn-amd-amdhsa--gfx950"
.text
.globl interleave_layers__sliding_block_cached__dense_activation_gelu__decode_kernel
.p2align 8
.type interleave_layers__sliding_block_cached__dense_activation_gelu__decode_kernel,@function
interleave_layers__sliding_block_cached__dense_activation_gelu__decode_kernel:
    s_cmp_ge_u32 s2, 256
    s_cbranch_scc1 L_end
    s_load_dwordx16 s[16:31], s[0:1], 0
    s_load_dwordx8 s[32:39], s[0:1], 64
    s_load_dwordx2 s[40:41], s[0:1], 96
    s_and_b32 s3, s2, 7
    s_lshr_b32 s4, s2, 3
    v_and_b32 v1, 63, v0
    v_lshrrev_b32 v20, 6, v0
    s_nop 0
    v_readfirstlane_b32 s5, v20
    s_mov_b32 s54, 0x3fb8aa3b
    s_mov_b32 s55, 0x3db504f3
    s_mov_b32 s56, 0x3b000000
    s_mov_b32 s57, 0x05040100
    s_mov_b32 s58, 0x07060302
    s_mov_b32 s59, 0xc0135761
    s_mov_b32 s60, 0xbdd2d3e8
    s_mov_b32 s61, 0x3727c5ac
    v_and_b32 v21, 15, v1
    v_lshrrev_b32 v22, 4, v1
    s_cmp_eq_u32 s5, 4
    s_cbranch_scc1 L_comm
    s_lshl_b32 s9, s3, 24
    s_lshl_b32 s10, s4, 15
    s_add_u32 s9, s9, s10
    s_lshl_b32 s10, s5, 13
    s_add_u32 s9, s9, s10
    s_add_u32 s9, s9, 15728640
    v_lshlrev_b32 v23, 8, v21
    v_lshl_add_u32 v23, v22, 4, v23
    v_add_u32 v24, 0x1000, v23
    s_waitcnt lgkmcnt(0)
    s_load_dword s8, s[40:41], 0
    s_add_u32 s12, s18, s9
    s_addc_u32 s13, s19, 0
    s_add_u32 s14, s20, s9
    s_addc_u32 s15, s21, 0
    s_lshl_b32 s10, s2, 14
    v_mov_b32 v240, s10
    s_lshl_b32 s10, s2, 12
    v_mov_b32 v241, s10
    v_mov_b32 v242, 0
    s_mov_b64 exec, 1
    global_load_dword v244, v242, s[12:13]
    global_load_dword v245, v242, s[14:15]
    global_load_dword v246, v240, s[24:25]
    global_load_dword v247, v241, s[28:29]
    global_load_dword v248, v241, s[32:33]
    global_load_dword v249, v242, s[30:31]
    s_mov_b64 exec, -1
    v_and_b32 v23, 3, v21
    v_mul_u32_u24 v2, 320, v23
    v_lshl_add_u32 v2, v22, 4, v2
    v_add_u32 v2, 26880, v2
    v_lshrrev_b32 v23, 2, v21
    v_lshl_add_u32 v23, v22, 3, v23
    v_lshlrev_b32 v19, 4, v23
    v_and_b32 v24, 1, v21
    v_lshl_add_u32 v19, v24, 3, v19
    v_and_b32 v24, 2, v21
    v_lshl_add_u32 v19, v24, 11, v19
    v_and_b32 v24, 1, v21
    v_mul_u32_u24 v16, 576, v24
    v_lshl_add_u32 v16, v22, 4, v16
    v_add_u32 v16, 25728, v16
    v_lshrrev_b32 v23, 3, v0
    s_lshl_b32 s10, s3, 5
    v_add_u32 v23, s10, v23
    v_lshlrev_b32 v23, 5, v23
    v_add_u32 v23, s4, v23
    v_lshlrev_b32 v23, 7, v23
    v_and_b32 v24, 7, v0
    v_lshl_add_u32 v3, v24, 4, v23
    s_lshl_b32 s9, s3, 2
    s_add_u32 s9, s9, s5
    s_lshl_b32 s9, s9, 5
    s_add_u32 s9, s9, s4
    s_lshl_b32 s9, s9, 4
    s_add_u32 s9, s9, 0x4000
    v_mov_b32 v4, s9
    s_mul_i32 s10, s5, 2336
    s_add_u32 s10, s10, 28288
    v_mul_u32_u24 v17, 576, v21
    v_lshl_add_u32 v17, v22, 4, v17
    v_add_u32 v17, s10, v17
    s_mul_i32 s10, s5, 576
    s_add_u32 s10, s10, 28288
    v_lshlrev_b32 v18, 3, v1
    v_add_u32 v18, s10, v18
    s_mov_b32 s50, 0x000f000f
    s_mov_b32 s51, 0x000f000f
    s_add_u32 s42, s40, 0x100000
    s_addc_u32 s43, s41, 0
    s_mov_b32 s44, 0
    s_mov_b32 s63, 0
    s_mov_b32 s49, 0
    s_getreg_b32 s45, hwreg(HW_REG_XCC_ID)
    s_and_b32 s45, s45, 7
    s_waitcnt lgkmcnt(0)
    s_xor_b32 s47, s8, 0x9e3779b9
    s_mov_b32 s6, s47
    s_mul_i32 s7, s8, 0x85ebca6b
    s_add_u32 s7, s7, 0xc2b2ae35
    s_xor_b32 s46, s7, s45
    s_barrier
    v_lshlrev_b32 v23, 8, v21
    v_lshl_add_u32 v23, v22, 4, v23
    v_add_u32 v24, 0x1000, v23
    global_load_dwordx4 v[32:35], v23, s[12:13] offset:0 nt
    global_load_dwordx4 v[36:39], v23, s[12:13] offset:64 nt
    global_load_dwordx4 v[40:43], v23, s[12:13] offset:128 nt
    global_load_dwordx4 v[44:47], v23, s[12:13] offset:192 nt
    global_load_dwordx4 v[48:51], v24, s[12:13] offset:0 nt
    global_load_dwordx4 v[52:55], v24, s[12:13] offset:64 nt
    global_load_dwordx4 v[56:59], v24, s[12:13] offset:128 nt
    global_load_dwordx4 v[60:63], v24, s[12:13] offset:192 nt
    v_lshlrev_b32 v23, 10, v22
    v_lshl_add_u32 v23, v21, 4, v23
    v_add_u32 v24, 0x1000, v23
    global_load_dwordx4 v[144:147], v23, s[14:15] offset:0 nt
    global_load_dwordx4 v[148:151], v23, s[14:15] offset:256 nt
    global_load_dwordx4 v[152:155], v23, s[14:15] offset:512 nt
    global_load_dwordx4 v[156:159], v23, s[14:15] offset:768 nt
    global_load_dwordx4 v[160:163], v24, s[14:15] offset:0 nt
    global_load_dwordx4 v[164:167], v24, s[14:15] offset:256 nt
    global_load_dwordx4 v[168:171], v24, s[14:15] offset:512 nt
    global_load_dwordx4 v[172:175], v24, s[14:15] offset:768 nt
    s_waitcnt vmcnt(0)
    v_perm_b32 v64, v148, v144, s57
    v_perm_b32 v65, v156, v152, s57
    v_perm_b32 v66, v164, v160, s57
    v_perm_b32 v67, v172, v168, s57
    v_perm_b32 v68, v148, v144, s58
    v_perm_b32 v69, v156, v152, s58
    v_perm_b32 v70, v164, v160, s58
    v_perm_b32 v71, v172, v168, s58
    v_perm_b32 v72, v149, v145, s57
    v_perm_b32 v73, v157, v153, s57
    v_perm_b32 v74, v165, v161, s57
    v_perm_b32 v75, v173, v169, s57
    v_perm_b32 v76, v149, v145, s58
    v_perm_b32 v77, v157, v153, s58
    v_perm_b32 v78, v165, v161, s58
    v_perm_b32 v79, v173, v169, s58
    v_perm_b32 v80, v150, v146, s57
    v_perm_b32 v81, v158, v154, s57
    v_perm_b32 v82, v166, v162, s57
    v_perm_b32 v83, v174, v170, s57
    v_perm_b32 v84, v150, v146, s58
    v_perm_b32 v85, v158, v154, s58
    v_perm_b32 v86, v166, v162, s58
    v_perm_b32 v87, v174, v170, s58
    v_perm_b32 v88, v151, v147, s57
    v_perm_b32 v89, v159, v155, s57
    v_perm_b32 v90, v167, v163, s57
    v_perm_b32 v91, v175, v171, s57
    v_perm_b32 v92, v151, v147, s58
    v_perm_b32 v93, v159, v155, s58
    v_perm_b32 v94, v167, v163, s58
    v_perm_b32 v95, v175, v171, s58
    s_lshl_b32 s9, s3, 2
    s_lshr_b32 s10, s4, 3
    s_add_u32 s9, s9, s10
    s_lshl_b32 s9, s9, 7
    s_and_b32 s10, s4, 7
    s_add_u32 s9, s9, s10
    s_lshl_b32 s9, s9, 10
    v_lshlrev_b32 v20, 2, v0
    v_add_u32 v20, s9, v20
    global_load_dword v112, v20, s[24:25] nt
    v_add_u32 v20, 0x2000, v20
    global_load_dword v113, v20, s[24:25] nt
    v_add_u32 v20, 0x2000, v20
    global_load_dword v114, v20, s[24:25] nt
    v_add_u32 v20, 0x2000, v20
    global_load_dword v115, v20, s[24:25] nt
    v_add_u32 v20, 0x2000, v20
    global_load_dword v116, v20, s[24:25] nt
    v_add_u32 v20, 0x2000, v20
    global_load_dword v117, v20, s[24:25] nt
    v_add_u32 v20, 0x2000, v20
    global_load_dword v118, v20, s[24:25] nt
    v_add_u32 v20, 0x2000, v20
    global_load_dword v119, v20, s[24:25] nt
    v_add_u32 v20, 0x2000, v20
    global_load_dword v120, v20, s[24:25] nt
    v_add_u32 v20, 0x2000, v20
    global_load_dword v121, v20, s[24:25] nt
    v_add_u32 v20, 0x2000, v20
    global_load_dword v122, v20, s[24:25] nt
    v_add_u32 v20, 0x2000, v20
    global_load_dword v123, v20, s[24:25] nt
    v_add_u32 v20, 0x2000, v20
    global_load_dword v124, v20, s[24:25] nt
    v_add_u32 v20, 0x2000, v20
    global_load_dword v125, v20, s[24:25] nt
    v_add_u32 v20, 0x2000, v20
    global_load_dword v126, v20, s[24:25] nt
    v_add_u32 v20, 0x2000, v20
    global_load_dword v127, v20, s[24:25] nt
    s_min_u32 s9, s4, 27
    s_mul_i32 s10, s3, 28
    s_add_u32 s9, s9, s10
    s_lshl_b32 s10, s9, 4
    v_mul_u32_u24 v23, 0xe00, v0
    v_add_u32 v23, s10, v23
    global_load_dwordx4 v[176:179], v23, s[28:29] nt
    v_add_u32 v23, 0xe0000, v23
    global_load_dwordx4 v[180:183], v23, s[28:29] nt
    v_and_b32 v23, 7, v1
    v_lshlrev_b32 v23, 1, v23
    v_add_u32 v23, s10, v23
    global_load_ushort v12, v23, s[30:31]
    s_lshl_b32 s10, s9, 13
    v_lshlrev_b32 v23, 2, v0
    v_add_u32 v23, s10, v23
    v_add_u32 v24, 0x1000, v23
    global_load_dword v136, v23, s[32:33] offset:0 nt
    global_load_dword v137, v23, s[32:33] offset:1024 nt
    global_load_dword v138, v23, s[32:33] offset:2048 nt
    global_load_dword v139, v23, s[32:33] offset:3072 nt
    global_load_dword v140, v24, s[32:33] offset:0 nt
    global_load_dword v141, v24, s[32:33] offset:1024 nt
    global_load_dword v142, v24, s[32:33] offset:2048 nt
    global_load_dword v143, v24, s[32:33] offset:3072 nt
L_cloop:
    s_barrier
    ds_read_b128 v[144:147], v2 offset:0
    ds_read_b128 v[148:151], v2 offset:64
    ds_read_b128 v[152:155], v2 offset:128
    ds_read_b128 v[156:159], v2 offset:192
    s_cmp_lg_u32 s63, 0
    s_cbranch_scc1 Lnf_1
    v_mov_b32 v24, 28224
    ds_read_b32 v23, v24
    s_waitcnt lgkmcnt(0)
    v_readfirstlane_b32 s44, v23
Lnf_1:
    s_waitcnt lgkmcnt(3)
    v_mfma_f32_16x16x32_bf16 v[240:243], v[32:35], v[144:147], 0
    v_mfma_f32_16x16x32_bf16 v[244:247], v[48:51], v[144:147], 0
    s_waitcnt lgkmcnt(2)
    v_mfma_f32_16x16x32_bf16 v[240:243], v[36:39], v[148:151], v[240:243]
    v_mfma_f32_16x16x32_bf16 v[244:247], v[52:55], v[148:151], v[244:247]
    s_waitcnt lgkmcnt(1)
    v_mfma_f32_16x16x32_bf16 v[240:243], v[40:43], v[152:155], v[240:243]
    v_mfma_f32_16x16x32_bf16 v[244:247], v[56:59], v[152:155], v[244:247]
    s_waitcnt lgkmcnt(0)
    v_mfma_f32_16x16x32_bf16 v[240:243], v[44:47], v[156:159], v[240:243]
    v_mfma_f32_16x16x32_bf16 v[244:247], v[60:63], v[156:159], v[244:247]
    s_nop 7
    s_nop 1
    v_cvt_pk_bf16_f32 v248, v240, v241
    v_cvt_pk_bf16_f32 v249, v242, v243
    v_cvt_pk_bf16_f32 v250, v244, v245
    v_cvt_pk_bf16_f32 v251, v246, v247
    v_lshlrev_b32 v240, 16, v248
    v_and_b32 v241, 0xffff0000, v248
    v_lshlrev_b32 v242, 16, v249
    v_and_b32 v243, 0xffff0000, v249
    v_lshlrev_b32 v244, 16, v250
    v_and_b32 v245, 0xffff0000, v250
    v_lshlrev_b32 v246, 16, v251
    v_and_b32 v247, 0xffff0000, v251
    v_mul_f32 v240, s55, v240
    v_mul_f32 v241, s55, v241
    v_mul_f32 v242, s55, v242
    v_mul_f32 v243, s55, v243
    v_mul_f32 v244, s55, v244
    v_mul_f32 v245, s55, v245
    v_mul_f32 v246, s55, v246
    v_mul_f32 v247, s55, v247
    v_cvt_pk_bf16_f32 v248, v240, v241
    v_cvt_pk_bf16_f32 v249, v242, v243
    v_cvt_pk_bf16_f32 v250, v244, v245
    v_cvt_pk_bf16_f32 v251, v246, v247
    v_lshlrev_b32 v240, 16, v248
    v_and_b32 v241, 0xffff0000, v248
    v_lshlrev_b32 v242, 16, v249
    v_and_b32 v243, 0xffff0000, v249
    v_lshlrev_b32 v244, 16, v250
    v_and_b32 v245, 0xffff0000, v250
    v_lshlrev_b32 v246, 16, v251
    v_and_b32 v247, 0xffff0000, v251
    v_max3_f32 v20, v240, v241, v242
    v_max3_f32 v21, v243, v244, v245
    v_max3_f32 v20, v246, v247, v20
    v_max_f32 v20, v20, v21
    v_mov_b32 v21, v20
    s_nop 1
    v_permlane16_swap_b32 v20, v21
    s_nop 1
    v_max_f32 v20, v20, v21
    v_mov_b32 v21, v20
    s_nop 1
    v_permlane32_swap_b32 v20, v21
    s_nop 1
    v_max_f32 v20, v20, v21
    v_mul_f32 v22, s54, v20
    v_fma_f32 v240, v240, s54, -v22
    v_fma_f32 v241, v241, s54, -v22
    v_fma_f32 v242, v242, s54, -v22
    v_fma_f32 v243, v243, s54, -v22
    v_fma_f32 v244, v244, s54, -v22
    v_fma_f32 v245, v245, s54, -v22
    v_fma_f32 v246, v246, s54, -v22
    v_fma_f32 v247, v247, s54, -v22
    v_exp_f32 v240, v240
    v_exp_f32 v241, v241
    v_exp_f32 v242, v242
    v_exp_f32 v243, v243
    v_exp_f32 v244, v244
    v_exp_f32 v245, v245
    v_exp_f32 v246, v246
    v_exp_f32 v247, v247
    s_nop 0
    v_cvt_pk_bf16_f32 v248, v240, v241
    v_cvt_pk_bf16_f32 v249, v242, v243
    v_cvt_pk_bf16_f32 v250, v244, v245
    v_cvt_pk_bf16_f32 v251, v246, v247
    v_add_f32 v21, v240, v241
    v_add_f32 v22, v242, v243
    v_mfma_f32_16x16x32_bf16 v[208:211], v[64:67], v[248:251], 0
    v_add_f32 v23, v244, v245
    v_add_f32 v24, v246, v247
    v_mfma_f32_16x16x32_bf16 v[212:215], v[68:71], v[248:251], 0
    v_add_f32 v21, v21, v22
    v_add_f32 v23, v23, v24
    v_mfma_f32_16x16x32_bf16 v[216:219], v[72:75], v[248:251], 0
    v_add_f32 v21, v21, v23
    v_mfma_f32_16x16x32_bf16 v[220:223], v[76:79], v[248:251], 0
    v_mov_b32 v22, v21
    s_nop 1
    v_permlane16_swap_b32 v21, v22
    s_nop 1
    v_add_f32 v21, v21, v22
    v_mov_b32 v22, v21
    s_nop 1
    v_permlane32_swap_b32 v21, v22
    s_nop 1
    v_add_f32 v21, v21, v22
    v_mfma_f32_16x16x32_bf16 v[224:227], v[80:83], v[248:251], 0
    v_mfma_f32_16x16x32_bf16 v[228:231], v[84:87], v[248:251], 0
    v_mfma_f32_16x16x32_bf16 v[232:235], v[88:91], v[248:251], 0
    v_mfma_f32_16x16x32_bf16 v[236:239], v[92:95], v[248:251], 0
    s_mul_i32 s10, s5, 2336
    s_add_u32 s10, s10, 30592
    v_lshlrev_b32 v22, 3, v1
    v_add_u32 v22, s10, v22
    s_mov_b64 exec, 0xf
    ds_write_b64 v22, v[20:21]
    s_mov_b64 exec, s[50:51]
    ds_write_b128 v17, v[208:211] offset:0
    ds_write_b128 v17, v[212:215] offset:64
    ds_write_b128 v17, v[216:219] offset:128
    ds_write_b128 v17, v[220:223] offset:192
    ds_write_b128 v17, v[224:227] offset:256
    ds_write_b128 v17, v[228:231] offset:320
    s_nop 3
    ds_write_b128 v17, v[232:235] offset:384
    ds_write_b128 v17, v[236:239] offset:448
    s_mov_b64 exec, -1
    s_lshl_b32 s10, s5, 3
    s_add_u32 s10, s10, 30592
    v_mov_b32 v22, s10
    s_add_u32 s6, s47, 1
    v_mov_b32 v242, s6
    v_mov_b32 v243, s7
    v_mov_b32 v246, s6
    v_mov_b32 v247, s7
    v_add_u32 v20, 0x100000, v3
    s_waitcnt lgkmcnt(0)
    s_barrier
    ds_read_b64 v[216:217], v22 offset:0
    ds_read_b64 v[218:219], v22 offset:2336
    ds_read_b64 v[220:221], v22 offset:4672
    ds_read_b64 v[222:223], v22 offset:7008
    ds_read_b64 v[208:209], v18 offset:0
    ds_read_b64 v[210:211], v18 offset:2336
    ds_read_b64 v[212:213], v18 offset:4672
    ds_read_b64 v[214:215], v18 offset:7008
    s_waitcnt lgkmcnt(4)
    v_max_f32 v244, v216, v218
    v_max3_f32 v244, v220, v222, v244
    v_sub_f32 v216, v216, v244
    v_sub_f32 v218, v218, v244
    v_sub_f32 v220, v220, v244
    v_sub_f32 v222, v222, v244
    v_mul_f32 v216, s54, v216
    v_mul_f32 v218, s54, v218
    v_mul_f32 v220, s54, v220
    v_mul_f32 v222, s54, v222
    v_exp_f32 v216, v216
    v_exp_f32 v218, v218
    v_exp_f32 v220, v220
    v_exp_f32 v222, v222
    s_waitcnt lgkmcnt(0)
    v_mul_f32 v240, v216, v208
    v_mul_f32 v241, v216, v209
    v_mul_f32 v245, v216, v217
    v_fmac_f32 v240, v218, v210
    v_fmac_f32 v241, v218, v211
    v_fmac_f32 v245, v218, v219
    v_fmac_f32 v240, v220, v212
    v_fmac_f32 v241, v220, v213
    v_fmac_f32 v245, v220, v221
    v_fmac_f32 v240, v222, v214
    v_fmac_f32 v241, v222, v215
    v_fmac_f32 v245, v222, v223
    s_cmp_eq_u32 s44, 1
    s_cbranch_scc1 Lpf_2
    global_store_dwordx4 v20, v[240:243], s[42:43] sc1
    s_branch Lpe_3
Lpf_2:
    global_store_dwordx4 v20, v[240:243], s[42:43]
Lpe_3:
    s_mov_b64 exec, 1
    s_cmp_eq_u32 s44, 1
    s_cbranch_scc1 Lpf_4
    global_store_dwordx4 v4, v[244:247], s[42:43] sc1
    s_branch Lpe_5
Lpf_4:
    global_store_dwordx4 v4, v[244:247], s[42:43]
Lpe_5:
    s_mov_b64 exec, -1
    s_cmp_lg_u32 s63, 0
    s_cbranch_scc1 Lnf_6
    s_waitcnt vmcnt(2)
    v_lshlrev_b32 v96, 16, v112
    v_and_b32 v112, 0xffff0000, v112
    v_lshlrev_b32 v97, 16, v113
    v_and_b32 v113, 0xffff0000, v113
    v_lshlrev_b32 v98, 16, v114
    v_and_b32 v114, 0xffff0000, v114
    v_lshlrev_b32 v99, 16, v115
    v_and_b32 v115, 0xffff0000, v115
    v_lshlrev_b32 v100, 16, v116
    v_and_b32 v116, 0xffff0000, v116
    v_lshlrev_b32 v101, 16, v117
    v_and_b32 v117, 0xffff0000, v117
    v_lshlrev_b32 v102, 16, v118
    v_and_b32 v118, 0xffff0000, v118
    v_lshlrev_b32 v103, 16, v119
    v_and_b32 v119, 0xffff0000, v119
    v_lshlrev_b32 v104, 16, v120
    v_and_b32 v120, 0xffff0000, v120
    v_lshlrev_b32 v105, 16, v121
    v_and_b32 v121, 0xffff0000, v121
    v_lshlrev_b32 v106, 16, v122
    v_and_b32 v122, 0xffff0000, v122
    v_lshlrev_b32 v107, 16, v123
    v_and_b32 v123, 0xffff0000, v123
    v_lshlrev_b32 v108, 16, v124
    v_and_b32 v124, 0xffff0000, v124
    v_lshlrev_b32 v109, 16, v125
    v_and_b32 v125, 0xffff0000, v125
    v_lshlrev_b32 v110, 16, v126
    v_and_b32 v126, 0xffff0000, v126
    v_lshlrev_b32 v111, 16, v127
    v_and_b32 v127, 0xffff0000, v127
    v_lshlrev_b32 v20, 4, v0
    ds_write_b128 v20, v[176:179] offset:16384
    ds_write_b128 v20, v[180:183] offset:20480
    v_lshlrev_b32 v128, 16, v136
    v_and_b32 v136, 0xffff0000, v136
    v_lshlrev_b32 v129, 16, v137
    v_and_b32 v137, 0xffff0000, v137
    v_lshlrev_b32 v130, 16, v138
    v_and_b32 v138, 0xffff0000, v138
    v_lshlrev_b32 v131, 16, v139
    v_and_b32 v139, 0xffff0000, v139
    v_lshlrev_b32 v132, 16, v140
    v_and_b32 v140, 0xffff0000, v140
    v_lshlrev_b32 v133, 16, v141
    v_and_b32 v141, 0xffff0000, v141
    v_lshlrev_b32 v134, 16, v142
    v_and_b32 v142, 0xffff0000, v142
    v_lshlrev_b32 v135, 16, v143
    v_and_b32 v143, 0xffff0000, v143
    v_lshlrev_b32 v12, 16, v12
    s_waitcnt lgkmcnt(0)
Lnf_6:
    s_add_u32 s6, s47, 2
    v_mov_b32 v250, s6
    v_mov_b32 v251, s7
    v_mov_b32 v21, 28160
    v_add_u32 v20, 0x200000, v3
    s_barrier
    ds_read_b128 v[208:211], v21 offset:0
    ds_read_b128 v[212:215], v21 offset:16
    ds_read_b128 v[216:219], v21 offset:32
    ds_read_b128 v[220:223], v21 offset:48
    s_waitcnt lgkmcnt(3)
    v_mul_f32 v248, v208, v96
    v_mul_f32 v249, v208, v112
    v_mul_f32 v244, v209, v97
    v_mul_f32 v245, v209, v113
    v_fmac_f32 v248, v210, v98
    v_fmac_f32 v249, v210, v114
    v_fmac_f32 v244, v211, v99
    v_fmac_f32 v245, v211, v115
    s_waitcnt lgkmcnt(2)
    v_fmac_f32 v248, v212, v100
    v_fmac_f32 v249, v212, v116
    v_fmac_f32 v244, v213, v101
    v_fmac_f32 v245, v213, v117
    v_fmac_f32 v248, v214, v102
    v_fmac_f32 v249, v214, v118
    v_fmac_f32 v244, v215, v103
    v_fmac_f32 v245, v215, v119
    s_waitcnt lgkmcnt(1)
    v_fmac_f32 v248, v216, v104
    v_fmac_f32 v249, v216, v120
    v_fmac_f32 v244, v217, v105
    v_fmac_f32 v245, v217, v121
    v_fmac_f32 v248, v218, v106
    v_fmac_f32 v249, v218, v122
    v_fmac_f32 v244, v219, v107
    v_fmac_f32 v245, v219, v123
    s_waitcnt lgkmcnt(0)
    v_fmac_f32 v248, v220, v108
    v_fmac_f32 v249, v220, v124
    v_fmac_f32 v244, v221, v109
    v_fmac_f32 v245, v221, v125
    v_fmac_f32 v248, v222, v110
    v_fmac_f32 v249, v222, v126
    v_fmac_f32 v244, v223, v111
    v_fmac_f32 v245, v223, v127
    v_add_f32 v248, v248, v244
    v_add_f32 v249, v249, v245
    s_cmp_eq_u32 s44, 1
    s_cbranch_scc1 Lpf_7
    global_store_dwordx4 v20, v[248:251], s[42:43] sc1
    s_branch Lpe_8
Lpf_7:
    global_store_dwordx4 v20, v[248:251], s[42:43]
Lpe_8:
    ds_read_b64_tr_b16 v[144:145], v19 offset:16384
    ds_read_b64_tr_b16 v[146:147], v19 offset:16448
    ds_read_b64_tr_b16 v[148:149], v19 offset:16896
    ds_read_b64_tr_b16 v[150:151], v19 offset:16960
    ds_read_b64_tr_b16 v[152:153], v19 offset:17408
    ds_read_b64_tr_b16 v[154:155], v19 offset:17472
    ds_read_b64_tr_b16 v[156:157], v19 offset:17920
    ds_read_b64_tr_b16 v[158:159], v19 offset:17984
    ds_read_b64_tr_b16 v[160:161], v19 offset:18432
    ds_read_b64_tr_b16 v[162:163], v19 offset:18496
    ds_read_b64_tr_b16 v[164:165], v19 offset:18944
    ds_read_b64_tr_b16 v[166:167], v19 offset:19008
    ds_read_b64_tr_b16 v[168:169], v19 offset:19456
    ds_read_b64_tr_b16 v[170:171], v19 offset:19520
    ds_read_b64_tr_b16 v[172:173], v19 offset:19968
    ds_read_b64_tr_b16 v[174:175], v19 offset:20032
    v_add_u32 v20, 0x200000, v3
    s_barrier
    ds_read_b128 v[208:211], v16 offset:0
    ds_read_b128 v[212:215], v16 offset:64
    ds_read_b128 v[216:219], v16 offset:128
    ds_read_b128 v[220:223], v16 offset:192
    ds_read_b128 v[224:227], v16 offset:256
    ds_read_b128 v[228:231], v16 offset:320
    ds_read_b128 v[232:235], v16 offset:384
    ds_read_b128 v[236:239], v16 offset:448
    s_waitcnt lgkmcnt(7)
    v_mfma_f32_16x16x32_bf16 v[240:243], v[208:211], v[144:147], 0
    s_waitcnt lgkmcnt(6)
    v_mfma_f32_16x16x32_bf16 v[240:243], v[212:215], v[148:151], v[240:243]
    s_waitcnt lgkmcnt(5)
    v_mfma_f32_16x16x32_bf16 v[240:243], v[216:219], v[152:155], v[240:243]
    s_waitcnt lgkmcnt(4)
    v_mfma_f32_16x16x32_bf16 v[240:243], v[220:223], v[156:159], v[240:243]
    s_waitcnt lgkmcnt(3)
    v_mfma_f32_16x16x32_bf16 v[240:243], v[224:227], v[160:163], v[240:243]
    s_waitcnt lgkmcnt(2)
    v_mfma_f32_16x16x32_bf16 v[240:243], v[228:231], v[164:167], v[240:243]
    s_waitcnt lgkmcnt(1)
    v_mfma_f32_16x16x32_bf16 v[240:243], v[232:235], v[168:171], v[240:243]
    s_waitcnt lgkmcnt(0)
    v_mfma_f32_16x16x32_bf16 v[240:243], v[236:239], v[172:175], v[240:243]
    s_nop 7
    s_nop 1
    v_add_f32_dpp v240, v241, v240 row_ror:8 row_mask:0xf bank_mask:0xf
    s_add_u32 s6, s47, 3
    v_mov_b32 v250, s6
    v_mov_b32 v251, s7
    v_cvt_pk_bf16_f32 v240, v240, v240
    v_and_b32 v240, 0xffff0000, v240
    v_add_f32 v240, v240, v12
    v_cvt_pk_bf16_f32 v240, v240, v240
    v_and_b32 v240, 0xffff0000, v240
    v_mul_f32 v241, v240, v240
    v_mov_b32 v242, s59
    v_fmac_f32 v242, s60, v241
    v_mul_f32 v242, v242, v240
    v_exp_f32 v242, v242
    s_nop 0
    v_add_f32 v242, 1.0, v242
    v_rcp_f32 v242, v242
    s_nop 0
    v_mul_f32 v240, v240, v242
    v_cvt_pk_bf16_f32 v240, v240, v240
    v_and_b32 v240, 0xffff0000, v240
    s_cmp_lt_u32 s4, 28
    s_cbranch_scc1 L_hok
    v_mov_b32 v240, 0
L_hok:
    s_nop 0
    v_readlane_b32 s64, v240, 0
    v_readlane_b32 s65, v240, 1
    v_readlane_b32 s66, v240, 2
    v_readlane_b32 s67, v240, 3
    v_readlane_b32 s68, v240, 4
    v_readlane_b32 s69, v240, 5
    v_readlane_b32 s70, v240, 6
    v_readlane_b32 s71, v240, 7
    v_mul_f32 v248, s64, v128
    v_mul_f32 v249, s64, v136
    v_mul_f32 v244, s65, v129
    v_mul_f32 v245, s65, v137
    v_fmac_f32 v248, s66, v130
    v_fmac_f32 v249, s66, v138
    v_fmac_f32 v244, s67, v131
    v_fmac_f32 v245, s67, v139
    v_fmac_f32 v248, s68, v132
    v_fmac_f32 v249, s68, v140
    v_fmac_f32 v244, s69, v133
    v_fmac_f32 v245, s69, v141
    v_fmac_f32 v248, s70, v134
    v_fmac_f32 v249, s70, v142
    v_fmac_f32 v244, s71, v135
    v_fmac_f32 v245, s71, v143
    v_add_f32 v248, v248, v244
    v_add_f32 v249, v249, v245
    s_cmp_eq_u32 s44, 1
    s_cbranch_scc1 Lpf_9
    global_store_dwordx4 v20, v[248:251], s[42:43] sc1
    s_branch Lpe_10
Lpf_9:
    global_store_dwordx4 v20, v[248:251], s[42:43]
Lpe_10:
    s_add_u32 s47, s47, 4
    s_add_u32 s63, s63, 1
    s_cmp_lt_u32 s63, 2
    s_cbranch_scc1 L_cloop
    s_endpgm
L_comm:
    s_setprio 3
    v_lshrrev_b32 v23, 2, v21
    v_lshl_add_u32 v23, v22, 3, v23
    v_and_b32 v24, 3, v21
    v_lshlrev_b32 v9, 5, v23
    v_lshl_add_u32 v9, v24, 3, v9
    v_lshlrev_b32 v16, 4, v22
    v_add_u32 v16, 24576, v16
    v_lshrrev_b32 v23, 1, v1
    v_lshlrev_b32 v23, 13, v23
    v_and_b32 v24, 1, v1
    v_lshl_add_u32 v23, v24, 4, v23
    s_lshl_b32 s9, s3, 10
    s_lshl_b32 s10, s4, 5
    s_add_u32 s9, s9, s10
    v_add_u32 v23, s9, v23
    v_lshlrev_b32 v15, 4, v1
    v_lshrrev_b32 v17, 5, v1
    v_lshl_add_u32 v17, v17, 6, v15
    v_mul_u32_u24 v18, 320, v22
    v_lshl_add_u32 v18, v21, 4, v18
    v_and_b32 v24, 7, v1
    v_lshlrev_b32 v24, 2, v24
    v_add_u32 v24, s10, v24
    s_waitcnt lgkmcnt(0)
    s_load_dword s8, s[40:41], 0
    global_load_dwordx4 v[28:31], v15, s[16:17]
    global_load_dwordx4 v[32:35], v23, s[22:23] nt
    v_add_u32 v23, 0x40000, v23
    global_load_dwordx4 v[36:39], v23, s[22:23] nt
    v_add_u32 v23, 0x40000, v23
    global_load_dwordx4 v[40:43], v23, s[22:23] nt
    v_add_u32 v23, 0x40000, v23
    global_load_dwordx4 v[44:47], v23, s[22:23] nt
    v_add_u32 v23, 0x40000, v23
    global_load_dwordx4 v[48:51], v23, s[22:23] nt
    v_add_u32 v23, 0x40000, v23
    global_load_dwordx4 v[52:55], v23, s[22:23] nt
    v_add_u32 v23, 0x40000, v23
    global_load_dwordx4 v[56:59], v23, s[22:23] nt
    v_add_u32 v23, 0x40000, v23
    global_load_dwordx4 v[60:63], v23, s[22:23] nt
    v_add_u32 v23, 0x40000, v23
    global_load_dwordx4 v[64:67], v23, s[22:23] nt
    v_add_u32 v23, 0x40000, v23
    global_load_dwordx4 v[68:71], v23, s[22:23] nt
    v_add_u32 v23, 0x40000, v23
    global_load_dwordx4 v[72:75], v23, s[22:23] nt
    v_add_u32 v23, 0x40000, v23
    global_load_dwordx4 v[76:79], v23, s[22:23] nt
    v_add_u32 v23, 0x40000, v23
    global_load_dwordx4 v[80:83], v23, s[22:23] nt
    v_add_u32 v23, 0x40000, v23
    global_load_dwordx4 v[84:87], v23, s[22:23] nt
    v_add_u32 v23, 0x40000, v23
    global_load_dwordx4 v[88:91], v23, s[22:23] nt
    v_add_u32 v23, 0x40000, v23
    global_load_dwordx4 v[92:95], v23, s[22:23] nt
    global_load_dword v11, v24, s[16:17]
    global_load_dword v14, v24, s[34:35]
    s_lshl_b32 s9, s3, 11
    v_lshlrev_b32 v2, 5, v1
    v_add_u32 v2, s9, v2
    v_add_u32 v8, 0x8000, v2
    s_lshl_b32 s10, s4, 6
    s_add_u32 s9, s9, s10
    v_and_b32 v26, 12, v1
    v_lshlrev_b32 v26, 2, v26
    v_add_u32 v26, s9, v26
    s_add_u32 s9, s9, 0x8000
    v_and_b32 v6, 6, v1
    v_lshlrev_b32 v6, 3, v6
    v_add_u32 v6, s9, v6
    s_lshl_b32 s9, s4, 10
    s_add_u32 s9, s9, 0x10000
    v_lshlrev_b32 v7, 4, v1
    v_add_u32 v7, s9, v7
    s_lshl_b32 s10, s3, 7
    s_add_u32 s9, s9, s10
    v_and_b32 v27, 7, v1
    v_lshlrev_b32 v27, 4, v27
    v_add_u32 v27, s9, v27
    s_lshl_b32 s10, s3, 5
    s_add_u32 s10, s10, s4
    s_lshl_b32 s10, s10, 12
    v_lshlrev_b32 v4, 4, v1
    v_add_u32 v4, s10, v4
    s_lshl_b32 s10, s3, 2
    s_lshr_b32 s11, s4, 3
    s_add_u32 s10, s10, s11
    s_lshl_b32 s10, s10, 9
    s_add_u32 s10, s10, 0x4000
    v_lshrrev_b32 v23, 3, v1
    v_lshlrev_b32 v5, 4, v23
    v_add_u32 v5, s10, v5
    s_add_u32 s42, s40, 0x100000
    s_addc_u32 s43, s41, 0
    s_mov_b32 s44, 0
    s_mov_b32 s63, 0
    s_mov_b32 s49, 0
    s_getreg_b32 s45, hwreg(HW_REG_XCC_ID)
    s_and_b32 s45, s45, 7
    s_waitcnt lgkmcnt(0)
    s_xor_b32 s47, s8, 0x9e3779b9
    s_mov_b32 s6, s47
    s_mul_i32 s7, s8, 0x85ebca6b
    s_add_u32 s7, s7, 0xc2b2ae35
    s_xor_b32 s46, s7, s45
    v_add_u32 v20, 0x100000, v4
    v_add_u32 v23, 0x200000, v4
    global_load_dword v96, v20, s[42:43] offset:0
    global_load_dword v100, v23, s[42:43] offset:0
    global_load_dword v97, v20, s[42:43] offset:1024
    global_load_dword v101, v23, s[42:43] offset:1024
    global_load_dword v98, v20, s[42:43] offset:2048
    global_load_dword v102, v23, s[42:43] offset:2048
    global_load_dword v99, v20, s[42:43] offset:3072
    global_load_dword v103, v23, s[42:43] offset:3072
    global_load_dword v104, v2, s[42:43]
    global_load_dword v105, v8, s[42:43]
    global_load_dword v106, v5, s[42:43] offset:0
    global_load_dword v107, v5, s[42:43] offset:128
    global_load_dword v108, v5, s[42:43] offset:256
    global_load_dword v109, v5, s[42:43] offset:384
    s_waitcnt vmcnt(31)
    ds_write_b128 v15, v[32:35] offset:0
    s_waitcnt vmcnt(30)
    ds_write_b128 v15, v[36:39] offset:1024
    s_waitcnt vmcnt(29)
    ds_write_b128 v15, v[40:43] offset:2048
    s_waitcnt vmcnt(28)
    ds_write_b128 v15, v[44:47] offset:3072
    s_waitcnt vmcnt(27)
    ds_write_b128 v15, v[48:51] offset:4096
    s_waitcnt vmcnt(26)
    ds_write_b128 v15, v[52:55] offset:5120
    s_waitcnt vmcnt(25)
    ds_write_b128 v15, v[56:59] offset:6144
    s_waitcnt vmcnt(24)
    ds_write_b128 v15, v[60:63] offset:7168
    s_waitcnt vmcnt(23)
    ds_write_b128 v15, v[64:67] offset:8192
    s_waitcnt vmcnt(22)
    ds_write_b128 v15, v[68:71] offset:9216
    s_waitcnt vmcnt(21)
    ds_write_b128 v15, v[72:75] offset:10240
    s_waitcnt vmcnt(20)
    ds_write_b128 v15, v[76:79] offset:11264
    s_waitcnt vmcnt(19)
    ds_write_b128 v15, v[80:83] offset:12288
    s_waitcnt vmcnt(18)
    ds_write_b128 v15, v[84:87] offset:13312
    s_waitcnt vmcnt(17)
    ds_write_b128 v15, v[88:91] offset:14336
    s_waitcnt vmcnt(16)
    ds_write_b128 v15, v[92:95] offset:15360
    ds_read_b64_tr_b16 v[144:145], v9 offset:0
    ds_read_b64_tr_b16 v[146:147], v9 offset:128
    ds_read_b64_tr_b16 v[148:149], v9 offset:1024
    ds_read_b64_tr_b16 v[150:151], v9 offset:1152
    ds_read_b64_tr_b16 v[152:153], v9 offset:2048
    ds_read_b64_tr_b16 v[154:155], v9 offset:2176
    ds_read_b64_tr_b16 v[156:157], v9 offset:3072
    ds_read_b64_tr_b16 v[158:159], v9 offset:3200
    ds_read_b64_tr_b16 v[160:161], v9 offset:4096
    ds_read_b64_tr_b16 v[162:163], v9 offset:4224
    ds_read_b64_tr_b16 v[164:165], v9 offset:5120
    ds_read_b64_tr_b16 v[166:167], v9 offset:5248
    ds_read_b64_tr_b16 v[168:169], v9 offset:6144
    ds_read_b64_tr_b16 v[170:171], v9 offset:6272
    ds_read_b64_tr_b16 v[172:173], v9 offset:7168
    ds_read_b64_tr_b16 v[174:175], v9 offset:7296
    ds_read_b64_tr_b16 v[176:177], v9 offset:8192
    ds_read_b64_tr_b16 v[178:179], v9 offset:8320
    ds_read_b64_tr_b16 v[180:181], v9 offset:9216
    ds_read_b64_tr_b16 v[182:183], v9 offset:9344
    ds_read_b64_tr_b16 v[184:185], v9 offset:10240
    ds_read_b64_tr_b16 v[186:187], v9 offset:10368
    ds_read_b64_tr_b16 v[188:189], v9 offset:11264
    ds_read_b64_tr_b16 v[190:191], v9 offset:11392
    ds_read_b64_tr_b16 v[192:193], v9 offset:12288
    ds_read_b64_tr_b16 v[194:195], v9 offset:12416
    ds_read_b64_tr_b16 v[196:197], v9 offset:13312
    ds_read_b64_tr_b16 v[198:199], v9 offset:13440
    ds_read_b64_tr_b16 v[200:201], v9 offset:14336
    ds_read_b64_tr_b16 v[202:203], v9 offset:14464
    ds_read_b64_tr_b16 v[204:205], v9 offset:15360
    ds_read_b64_tr_b16 v[206:207], v9 offset:15488
L_mloop:
    s_add_u32 s6, s47, 0
    v_lshlrev_b32 v240, 16, v28
    v_and_b32 v241, 0xffff0000, v28
    v_lshlrev_b32 v242, 16, v29
    v_and_b32 v243, 0xffff0000, v29
    v_lshlrev_b32 v244, 16, v30
    v_and_b32 v245, 0xffff0000, v30
    v_lshlrev_b32 v246, 16, v31
    v_and_b32 v247, 0xffff0000, v31
    v_readfirstlane_b32 s11, v240
    s_nop 1
    v_subrev_f32 v248, s11, v240
    v_subrev_f32 v249, s11, v241
    v_subrev_f32 v250, s11, v242
    v_subrev_f32 v251, s11, v243
    v_subrev_f32 v252, s11, v244
    v_subrev_f32 v253, s11, v245
    v_subrev_f32 v254, s11, v246
    v_subrev_f32 v255, s11, v247
    v_add_f32 v20, v248, v249
    v_mul_f32 v21, v248, v248
    v_add_f32 v22, v250, v251
    v_mul_f32 v23, v249, v249
    v_fmac_f32 v21, v250, v250
    v_fmac_f32 v23, v251, v251
    v_fmac_f32 v21, v252, v252
    v_fmac_f32 v23, v253, v253
    v_fmac_f32 v21, v254, v254
    v_fmac_f32 v23, v255, v255
    v_add_f32 v20, v20, v252
    v_add_f32 v22, v22, v253
    v_add_f32 v20, v20, v254
    v_add_f32 v22, v22, v255
    v_add_f32 v21, v21, v23
    v_add_f32 v20, v20, v22
    s_nop 0
    v_add_f32_dpp v21, v21, v21 quad_perm:[1,0,3,2] row_mask:0xf bank_mask:0xf
    v_add_f32_dpp v20, v20, v20 quad_perm:[1,0,3,2] row_mask:0xf bank_mask:0xf
    s_nop 0
    v_add_f32_dpp v21, v21, v21 quad_perm:[2,3,0,1] row_mask:0xf bank_mask:0xf
    v_add_f32_dpp v20, v20, v20 quad_perm:[2,3,0,1] row_mask:0xf bank_mask:0xf
    s_nop 0
    v_add_f32_dpp v21, v21, v21 row_half_mirror row_mask:0xf bank_mask:0xf
    v_add_f32_dpp v20, v20, v20 row_half_mirror row_mask:0xf bank_mask:0xf
    s_nop 0
    v_add_f32_dpp v21, v21, v21 row_mirror row_mask:0xf bank_mask:0xf
    v_add_f32_dpp v20, v20, v20 row_mirror row_mask:0xf bank_mask:0xf
    v_mov_b32 v23, v21
    v_mov_b32 v22, v20
    s_nop 0
    v_permlane16_swap_b32 v21, v23
    v_permlane16_swap_b32 v20, v22
    s_nop 0
    v_add_f32 v21, v21, v23
    v_add_f32 v20, v20, v22
    v_mov_b32 v23, v21
    v_mov_b32 v22, v20
    s_nop 0
    v_permlane32_swap_b32 v21, v23
    v_permlane32_swap_b32 v20, v22
    s_nop 0
    v_add_f32 v21, v21, v23
    v_add_f32 v20, v20, v22
    v_mul_f32 v20, s56, v20
    v_mul_f32 v21, s56, v21
    v_fma_f32 v21, -v20, v20, v21
    v_add_f32 v20, s11, v20
    v_max_f32 v21, 0, v21
    v_cvt_pk_bf16_f32 v22, v20, v21
    v_lshlrev_b32 v20, 16, v22
    v_and_b32 v21, 0xffff0000, v22
    v_add_f32 v21, s61, v21
    v_sub_f32 v240, v240, v20
    v_sub_f32 v241, v241, v20
    v_sub_f32 v242, v242, v20
    v_sub_f32 v243, v243, v20
    v_cvt_pk_bf16_f32 v21, v21, v21
    v_sub_f32 v244, v244, v20
    v_sub_f32 v245, v245, v20
    v_sub_f32 v246, v246, v20
    v_sub_f32 v247, v247, v20
    v_and_b32 v21, 0xffff0000, v21
    v_sqrt_f32 v21, v21
    v_cvt_pk_bf16_f32 v248, v240, v241
    v_cvt_pk_bf16_f32 v249, v242, v243
    v_cvt_pk_bf16_f32 v250, v244, v245
    v_cvt_pk_bf16_f32 v251, v246, v247
    v_cvt_pk_bf16_f32 v21, v21, v21
    v_and_b32 v21, 0xffff0000, v21
    v_rcp_f32 v21, v21
    v_lshlrev_b32 v240, 16, v248
    v_and_b32 v241, 0xffff0000, v248
    v_lshlrev_b32 v242, 16, v249
    v_and_b32 v243, 0xffff0000, v249
    v_lshlrev_b32 v244, 16, v250
    v_and_b32 v245, 0xffff0000, v250
    v_lshlrev_b32 v246, 16, v251
    v_and_b32 v247, 0xffff0000, v251
    v_mul_f32 v240, v240, v21
    v_mul_f32 v241, v241, v21
    v_mul_f32 v242, v242, v21
    v_mul_f32 v243, v243, v21
    v_mul_f32 v244, v244, v21
    v_mul_f32 v245, v245, v21
    v_mul_f32 v246, v246, v21
    v_mul_f32 v247, v247, v21
    v_cvt_pk_bf16_f32 v252, v240, v241
    v_cvt_pk_bf16_f32 v253, v242, v243
    v_cvt_pk_bf16_f32 v254, v244, v245
    v_cvt_pk_bf16_f32 v255, v246, v247
    ds_write_b128 v17, v[252:255] offset:24576
    ds_read_b128 v[208:211], v16 offset:0
    ds_read_b128 v[212:215], v16 offset:64
    ds_read_b128 v[216:219], v16 offset:128
    ds_read_b128 v[220:223], v16 offset:192
    ds_read_b128 v[224:227], v16 offset:256
    ds_read_b128 v[228:231], v16 offset:320
    ds_read_b128 v[232:235], v16 offset:384
    ds_read_b128 v[236:239], v16 offset:448
    s_waitcnt lgkmcnt(7)
    v_mfma_f32_16x16x32_bf16 v[240:243], v[208:211], v[144:147], 0
    ds_read_b128 v[208:211], v16 offset:576
    s_waitcnt lgkmcnt(7)
    v_mfma_f32_16x16x32_bf16 v[240:243], v[212:215], v[148:151], v[240:243]
    ds_read_b128 v[212:215], v16 offset:640
    s_waitcnt lgkmcnt(7)
    v_mfma_f32_16x16x32_bf16 v[240:243], v[216:219], v[152:155], v[240:243]
    ds_read_b128 v[216:219], v16 offset:704
    s_waitcnt lgkmcnt(7)
    v_mfma_f32_16x16x32_bf16 v[240:243], v[220:223], v[156:159], v[240:243]
    ds_read_b128 v[220:223], v16 offset:768
    s_waitcnt lgkmcnt(7)
    v_mfma_f32_16x16x32_bf16 v[240:243], v[224:227], v[160:163], v[240:243]
    ds_read_b128 v[224:227], v16 offset:832
    s_waitcnt lgkmcnt(7)
    v_mfma_f32_16x16x32_bf16 v[240:243], v[228:231], v[164:167], v[240:243]
    ds_read_b128 v[228:231], v16 offset:896
    s_waitcnt lgkmcnt(7)
    v_mfma_f32_16x16x32_bf16 v[240:243], v[232:235], v[168:171], v[240:243]
    ds_read_b128 v[232:235], v16 offset:960
    s_waitcnt lgkmcnt(7)
    v_mfma_f32_16x16x32_bf16 v[240:243], v[236:239], v[172:175], v[240:243]
    ds_read_b128 v[236:239], v16 offset:1024
    s_waitcnt lgkmcnt(7)
    v_mfma_f32_16x16x32_bf16 v[240:243], v[208:211], v[176:179], v[240:243]
    s_waitcnt lgkmcnt(6)
    v_mfma_f32_16x16x32_bf16 v[240:243], v[212:215], v[180:183], v[240:243]
    s_waitcnt lgkmcnt(5)
    v_mfma_f32_16x16x32_bf16 v[240:243], v[216:219], v[184:187], v[240:243]
    s_waitcnt lgkmcnt(4)
    v_mfma_f32_16x16x32_bf16 v[240:243], v[220:223], v[188:191], v[240:243]
    s_waitcnt lgkmcnt(3)
    v_mfma_f32_16x16x32_bf16 v[240:243], v[224:227], v[192:195], v[240:243]
    s_waitcnt lgkmcnt(2)
    v_mfma_f32_16x16x32_bf16 v[240:243], v[228:231], v[196:199], v[240:243]
    s_waitcnt lgkmcnt(1)
    v_mfma_f32_16x16x32_bf16 v[240:243], v[232:235], v[200:203], v[240:243]
    s_waitcnt lgkmcnt(0)
    v_mfma_f32_16x16x32_bf16 v[240:243], v[236:239], v[204:207], v[240:243]
    s_nop 7
    s_nop 1
    v_mov_b32_dpp v248, v240 quad_perm:[0,0,0,0] row_mask:0xf bank_mask:0xf
    v_mov_b32_dpp v249, v240 quad_perm:[1,1,1,1] row_mask:0xf bank_mask:0xf
    v_mov_b32_dpp v250, v240 quad_perm:[2,2,2,2] row_mask:0xf bank_mask:0xf
    v_mov_b32_dpp v251, v240 quad_perm:[3,3,3,3] row_mask:0xf bank_mask:0xf
    v_mov_b32 v246, s6
    v_mov_b32 v247, s46
    v_cvt_pk_bf16_f32 v244, v248, v249
    v_cvt_pk_bf16_f32 v245, v250, v251
    s_mov_b64 exec, 0x1111
    s_cmp_eq_u32 s44, 1
    s_cbranch_scc1 Lpf_11
    global_store_dwordx4 v26, v[244:247], s[42:43] sc1
    s_branch Lpe_12
Lpf_11:
    global_store_dwordx4 v26, v[244:247], s[42:43]
Lpe_12:
    s_mov_b64 exec, -1
    s_cmp_lg_u32 s63, 0
    s_cbranch_scc1 Lnf_13
    s_barrier
Lnf_13:
    s_mov_b32 s48, 0
Lpoll_14:
    global_load_dwordx4 v[208:211], v2, s[42:43] offset:0 sc1
    global_load_dwordx4 v[212:215], v2, s[42:43] offset:16 sc1
    s_add_u32 s48, s48, 1
    s_cmp_gt_u32 s48, 400000
    s_cbranch_scc1 L_end
    s_waitcnt vmcnt(1)
    v_xor_b32 v23, s6, v210
    v_xor_b32 v24, s7, v211
    v_lshrrev_b32 v24, 3, v24
    v_or_b32 v25, v23, v24
    s_waitcnt vmcnt(0)
    v_xor_b32 v23, s6, v214
    v_xor_b32 v24, s7, v215
    v_lshrrev_b32 v24, 3, v24
    v_or3_b32 v25, v23, v24, v25
    v_cmp_ne_u32 vcc, 0, v25
    s_cbranch_vccnz Lpoll_14
    s_cmp_lg_u32 s63, 0
    s_cbranch_scc1 Lnf_15
    v_lshlrev_b32 v10, 16, v11
    v_and_b32 v11, 0xffff0000, v11
    v_lshlrev_b32 v13, 16, v14
    v_and_b32 v14, 0xffff0000, v14
    v_xor_b32 v24, s46, v211
    v_xor_b32 v23, s46, v215
    v_or_b32 v24, v24, v23
    v_cmp_ne_u32 vcc, 0, v24
    s_cmp_eq_u64 vcc, 0
    s_cselect_b32 s44, 1, 0
    v_mov_b32 v23, s44
    v_mov_b32 v24, 28224
    ds_write_b32 v24, v23
Lnf_15:
    v_mov_b32 v210, v212
    v_mov_b32 v211, v213
    ds_write_b128 v18, v[208:211] offset:26880
    v_add_u32 v20, 0x100000, v4
    s_waitcnt lgkmcnt(0)
    s_barrier
    s_barrier
    s_add_u32 s6, s47, 1
    s_mov_b32 s48, 0
Lpoll_16:
    global_load_dwordx4 v[160:163], v5, s[42:43] offset:0 sc1
    global_load_dwordx4 v[164:167], v5, s[42:43] offset:128 sc1
    global_load_dwordx4 v[168:171], v5, s[42:43] offset:256 sc1
    global_load_dwordx4 v[172:175], v5, s[42:43] offset:384 sc1
    global_load_dwordx4 v[144:147], v20, s[42:43] offset:0 sc1
    global_load_dwordx4 v[148:151], v20, s[42:43] offset:1024 sc1
    global_load_dwordx4 v[152:155], v20, s[42:43] offset:2048 sc1
    global_load_dwordx4 v[156:159], v20, s[42:43] offset:3072 sc1
    s_add_u32 s48, s48, 1
    s_cmp_gt_u32 s48, 400000
    s_cbranch_scc1 L_end
    s_waitcnt vmcnt(7)
    v_xor_b32 v23, s6, v162
    v_xor_b32 v24, s7, v163
    v_or_b32 v25, v23, v24
    s_waitcnt vmcnt(6)
    v_xor_b32 v23, s6, v166
    v_xor_b32 v24, s7, v167
    v_or3_b32 v25, v23, v24, v25
    s_waitcnt vmcnt(5)
    v_xor_b32 v23, s6, v170
    v_xor_b32 v24, s7, v171
    v_or3_b32 v25, v23, v24, v25
    s_waitcnt vmcnt(4)
    v_xor_b32 v23, s6, v174
    v_xor_b32 v24, s7, v175
    v_or3_b32 v25, v23, v24, v25
    s_waitcnt vmcnt(3)
    v_xor_b32 v23, s6, v146
    v_xor_b32 v24, s7, v147
    v_or3_b32 v25, v23, v24, v25
    s_waitcnt vmcnt(2)
    v_xor_b32 v23, s6, v150
    v_xor_b32 v24, s7, v151
    v_or3_b32 v25, v23, v24, v25
    s_waitcnt vmcnt(1)
    v_xor_b32 v23, s6, v154
    v_xor_b32 v24, s7, v155
    v_or3_b32 v25, v23, v24, v25
    s_waitcnt vmcnt(0)
    v_xor_b32 v23, s6, v158
    v_xor_b32 v24, s7, v159
    v_or3_b32 v25, v23, v24, v25
    v_cmp_ne_u32 vcc, 0, v25
    s_cbranch_vccnz Lpoll_16
    v_max_f32 v20, v160, v164
    v_max3_f32 v20, v168, v172, v20
    s_nop 1
    v_max_f32_dpp v20, v20, v20 row_ror:8 row_mask:0xf bank_mask:0xf
    v_mov_b32 v21, v20
    s_nop 1
    v_permlane16_swap_b32 v20, v21
    s_nop 1
    v_max_f32 v20, v20, v21
    v_mov_b32 v21, v20
    s_nop 1
    v_permlane32_swap_b32 v20, v21
    s_nop 1
    v_max_f32 v20, v20, v21
    v_sub_f32 v160, v160, v20
    v_sub_f32 v164, v164, v20
    v_sub_f32 v168, v168, v20
    v_sub_f32 v172, v172, v20
    v_mul_f32 v160, s54, v160
    v_mul_f32 v164, s54, v164
    v_mul_f32 v168, s54, v168
    v_mul_f32 v172, s54, v172
    v_exp_f32 v160, v160
    v_exp_f32 v164, v164
    v_exp_f32 v168, v168
    v_exp_f32 v172, v172
    v_lshlrev_b32 v22, 3, v1
    v_mul_f32 v240, v160, v144
    v_mul_f32 v241, v160, v145
    v_mul_f32 v242, v160, v161
    v_fmac_f32 v240, v164, v148
    v_fmac_f32 v241, v164, v149
    v_fmac_f32 v242, v164, v165
    v_fmac_f32 v240, v168, v152
    v_fmac_f32 v241, v168, v153
    v_fmac_f32 v242, v168, v169
    v_fmac_f32 v240, v172, v156
    v_fmac_f32 v241, v172, v157
    v_fmac_f32 v242, v172, v173
    s_nop 0
    v_add_f32_dpp v240, v240, v240 row_ror:8 row_mask:0xf bank_mask:0xf
    v_add_f32_dpp v241, v241, v241 row_ror:8 row_mask:0xf bank_mask:0xf
    v_add_f32_dpp v242, v242, v242 row_ror:8 row_mask:0xf bank_mask:0xf
    v_mov_b32 v244, v240
    v_mov_b32 v245, v241
    v_mov_b32 v246, v242
    s_nop 0
    v_permlane16_swap_b32 v240, v244
    v_permlane16_swap_b32 v241, v245
    v_permlane16_swap_b32 v242, v246
    s_nop 0
    v_add_f32 v240, v240, v244
    v_add_f32 v241, v241, v245
    v_add_f32 v242, v242, v246
    v_mov_b32 v244, v240
    v_mov_b32 v245, v241
    v_mov_b32 v246, v242
    s_nop 0
    v_permlane32_swap_b32 v240, v244
    v_permlane32_swap_b32 v241, v245
    v_permlane32_swap_b32 v242, v246
    s_nop 0
    v_add_f32 v240, v240, v244
    v_add_f32 v241, v241, v245
    v_add_f32 v242, v242, v246
    v_rcp_f32 v242, v242
    s_nop 0
    v_mul_f32 v240, v240, v242
    v_mul_f32 v241, v241, v242
    v_cvt_pk_bf16_f32 v242, v240, v241
    v_lshlrev_b32 v240, 16, v242
    v_and_b32 v241, 0xffff0000, v242
    s_mov_b64 exec, 0xff
    ds_write_b64 v22, v[240:241] offset:28160
    s_mov_b64 exec, -1
    s_waitcnt lgkmcnt(0)
    s_barrier
    s_add_u32 s6, s47, 2
    v_add_u32 v20, 0x200000, v4
    v_mov_b32 v242, s6
    v_mov_b32 v243, s7
    s_mov_b32 s48, 0
Lpoll_17:
    global_load_dwordx4 v[208:211], v20, s[42:43] offset:0 sc1
    global_load_dwordx4 v[212:215], v20, s[42:43] offset:1024 sc1
    global_load_dwordx4 v[216:219], v20, s[42:43] offset:2048 sc1
    global_load_dwordx4 v[220:223], v20, s[42:43] offset:3072 sc1
    s_add_u32 s48, s48, 1
    s_cmp_gt_u32 s48, 400000
    s_cbranch_scc1 L_end
    s_waitcnt vmcnt(3)
    v_xor_b32 v23, s6, v210
    v_xor_b32 v24, s7, v211
    v_or_b32 v25, v23, v24
    s_waitcnt vmcnt(2)
    v_xor_b32 v23, s6, v214
    v_xor_b32 v24, s7, v215
    v_or3_b32 v25, v23, v24, v25
    s_waitcnt vmcnt(1)
    v_xor_b32 v23, s6, v218
    v_xor_b32 v24, s7, v219
    v_or3_b32 v25, v23, v24, v25
    s_waitcnt vmcnt(0)
    v_xor_b32 v23, s6, v222
    v_xor_b32 v24, s7, v223
    v_or3_b32 v25, v23, v24, v25
    v_cmp_ne_u32 vcc, 0, v25
    s_cbranch_vccnz Lpoll_17
    v_add_f32 v240, v208, v212
    v_add_f32 v244, v216, v220
    v_add_f32 v241, v209, v213
    v_add_f32 v245, v217, v221
    v_add_f32 v240, v240, v244
    v_add_f32 v241, v241, v245
    s_nop 0
    v_add_f32_dpp v240, v240, v240 row_ror:8 row_mask:0xf bank_mask:0xf
    v_add_f32_dpp v241, v241, v241 row_ror:8 row_mask:0xf bank_mask:0xf
    v_mov_b32 v244, v240
    v_mov_b32 v245, v241
    s_nop 0
    v_permlane16_swap_b32 v240, v244
    v_permlane16_swap_b32 v241, v245
    s_nop 0
    v_add_f32 v240, v240, v244
    v_add_f32 v241, v241, v245
    v_mov_b32 v244, v240
    v_mov_b32 v245, v241
    s_nop 0
    v_permlane32_swap_b32 v240, v244
    v_permlane32_swap_b32 v241, v245
    s_nop 0
    v_add_f32 v240, v240, v244
    v_add_f32 v241, v241, v245
    v_add_u32 v20, s49, v27
    s_mov_b64 exec, 0xff
    global_store_dwordx4 v20, v[240:243], s[42:43] sc1
    s_mov_b64 exec, -1
    v_add_u32 v20, s49, v7
    s_add_u32 s49, s49, 0x8000
    s_mov_b32 s48, 0
Lpoll_18:
    global_load_dwordx4 v[208:211], v20, s[42:43] offset:0 sc1
    s_add_u32 s48, s48, 1
    s_cmp_gt_u32 s48, 400000
    s_cbranch_scc1 L_end
    s_waitcnt vmcnt(0)
    v_xor_b32 v23, s6, v210
    v_xor_b32 v24, s7, v211
    v_or_b32 v25, v23, v24
    v_cmp_ne_u32 vcc, 0, v25
    s_cbranch_vccnz Lpoll_18
    s_nop 0
    v_add_f32_dpp v208, v208, v208 row_ror:8 row_mask:0xf bank_mask:0xf
    v_add_f32_dpp v209, v209, v209 row_ror:8 row_mask:0xf bank_mask:0xf
    v_mov_b32 v244, v208
    v_mov_b32 v245, v209
    s_nop 0
    v_permlane16_swap_b32 v208, v244
    v_permlane16_swap_b32 v209, v245
    s_nop 0
    v_add_f32 v208, v208, v244
    v_add_f32 v209, v209, v245
    v_mov_b32 v244, v208
    v_mov_b32 v245, v209
    s_nop 0
    v_permlane32_swap_b32 v208, v244
    v_permlane32_swap_b32 v209, v245
    s_nop 0
    v_add_f32 v208, v208, v244
    v_add_f32 v209, v209, v245
    v_cvt_pk_bf16_f32 v21, v208, v209
    v_lshlrev_b32 v208, 16, v21
    v_and_b32 v209, 0xffff0000, v21
    v_add_f32 v208, v208, v10
    v_add_f32 v209, v209, v11
    v_cvt_pk_bf16_f32 v240, v208, v209
    v_lshlrev_b32 v10, 16, v240
    v_and_b32 v11, 0xffff0000, v240
    v_mov_b32_dpp v241, v240 quad_perm:[1,1,3,3] row_mask:0xf bank_mask:0xf
    s_mov_b64 exec, 0x55
    s_cmp_eq_u32 s44, 1
    s_cbranch_scc1 Lpf_19
    global_store_dwordx4 v6, v[240:243], s[42:43] sc1
    s_branch Lpe_20
Lpf_19:
    global_store_dwordx4 v6, v[240:243], s[42:43]
Lpe_20:
    s_mov_b64 exec, -1
    s_mov_b32 s48, 0
Lpoll_21:
    global_load_dwordx4 v[216:219], v8, s[42:43] offset:0 sc1
    global_load_dwordx4 v[220:223], v8, s[42:43] offset:16 sc1
    s_add_u32 s48, s48, 1
    s_cmp_gt_u32 s48, 400000
    s_cbranch_scc1 L_end
    s_waitcnt vmcnt(1)
    v_xor_b32 v23, s6, v218
    v_xor_b32 v24, s7, v219
    v_or_b32 v25, v23, v24
    s_waitcnt vmcnt(0)
    v_xor_b32 v23, s6, v222
    v_xor_b32 v24, s7, v223
    v_or3_b32 v25, v23, v24, v25
    v_cmp_ne_u32 vcc, 0, v25
    s_cbranch_vccnz Lpoll_21
    v_lshlrev_b32 v240, 16, v216
    v_and_b32 v241, 0xffff0000, v216
    v_lshlrev_b32 v242, 16, v217
    v_and_b32 v243, 0xffff0000, v217
    v_lshlrev_b32 v244, 16, v220
    v_and_b32 v245, 0xffff0000, v220
    v_lshlrev_b32 v246, 16, v221
    v_and_b32 v247, 0xffff0000, v221
    v_readfirstlane_b32 s11, v240
    s_nop 1
    v_subrev_f32 v248, s11, v240
    v_subrev_f32 v249, s11, v241
    v_subrev_f32 v250, s11, v242
    v_subrev_f32 v251, s11, v243
    v_subrev_f32 v252, s11, v244
    v_subrev_f32 v253, s11, v245
    v_subrev_f32 v254, s11, v246
    v_subrev_f32 v255, s11, v247
    v_add_f32 v20, v248, v249
    v_mul_f32 v21, v248, v248
    v_add_f32 v22, v250, v251
    v_mul_f32 v23, v249, v249
    v_fmac_f32 v21, v250, v250
    v_fmac_f32 v23, v251, v251
    v_fmac_f32 v21, v252, v252
    v_fmac_f32 v23, v253, v253
    v_fmac_f32 v21, v254, v254
    v_fmac_f32 v23, v255, v255
    v_add_f32 v20, v20, v252
    v_add_f32 v22, v22, v253
    v_add_f32 v20, v20, v254
    v_add_f32 v22, v22, v255
    v_add_f32 v21, v21, v23
    v_add_f32 v20, v20, v22
    s_nop 0
    v_add_f32_dpp v21, v21, v21 quad_perm:[1,0,3,2] row_mask:0xf bank_mask:0xf
    v_add_f32_dpp v20, v20, v20 quad_perm:[1,0,3,2] row_mask:0xf bank_mask:0xf
    s_nop 0
    v_add_f32_dpp v21, v21, v21 quad_perm:[2,3,0,1] row_mask:0xf bank_mask:0xf
    v_add_f32_dpp v20, v20, v20 quad_perm:[2,3,0,1] row_mask:0xf bank_mask:0xf
    s_nop 0
    v_add_f32_dpp v21, v21, v21 row_half_mirror row_mask:0xf bank_mask:0xf
    v_add_f32_dpp v20, v20, v20 row_half_mirror row_mask:0xf bank_mask:0xf
    s_nop 0
    v_add_f32_dpp v21, v21, v21 row_mirror row_mask:0xf bank_mask:0xf
    v_add_f32_dpp v20, v20, v20 row_mirror row_mask:0xf bank_mask:0xf
    v_mov_b32 v23, v21
    v_mov_b32 v22, v20
    s_nop 0
    v_permlane16_swap_b32 v21, v23
    v_permlane16_swap_b32 v20, v22
    s_nop 0
    v_add_f32 v21, v21, v23
    v_add_f32 v20, v20, v22
    v_mov_b32 v23, v21
    v_mov_b32 v22, v20
    s_nop 0
    v_permlane32_swap_b32 v21, v23
    v_permlane32_swap_b32 v20, v22
    s_nop 0
    v_add_f32 v21, v21, v23
    v_add_f32 v20, v20, v22
    v_mul_f32 v20, s56, v20
    v_mul_f32 v21, s56, v21
    v_fma_f32 v21, -v20, v20, v21
    v_add_f32 v20, s11, v20
    v_max_f32 v21, 0, v21
    v_cvt_pk_bf16_f32 v22, v20, v21
    v_lshlrev_b32 v20, 16, v22
    v_and_b32 v21, 0xffff0000, v22
    v_add_f32 v21, s61, v21
    v_sub_f32 v240, v240, v20
    v_sub_f32 v241, v241, v20
    v_sub_f32 v242, v242, v20
    v_sub_f32 v243, v243, v20
    v_cvt_pk_bf16_f32 v21, v21, v21
    v_sub_f32 v244, v244, v20
    v_sub_f32 v245, v245, v20
    v_sub_f32 v246, v246, v20
    v_sub_f32 v247, v247, v20
    v_and_b32 v21, 0xffff0000, v21
    v_sqrt_f32 v21, v21
    v_cvt_pk_bf16_f32 v248, v240, v241
    v_cvt_pk_bf16_f32 v249, v242, v243
    v_cvt_pk_bf16_f32 v250, v244, v245
    v_cvt_pk_bf16_f32 v251, v246, v247
    v_cvt_pk_bf16_f32 v21, v21, v21
    v_and_b32 v21, 0xffff0000, v21
    v_rcp_f32 v21, v21
    v_lshlrev_b32 v240, 16, v248
    v_and_b32 v241, 0xffff0000, v248
    v_lshlrev_b32 v242, 16, v249
    v_and_b32 v243, 0xffff0000, v249
    v_lshlrev_b32 v244, 16, v250
    v_and_b32 v245, 0xffff0000, v250
    v_lshlrev_b32 v246, 16, v251
    v_and_b32 v247, 0xffff0000, v251
    v_mul_f32 v240, v240, v21
    v_mul_f32 v241, v241, v21
    v_mul_f32 v242, v242, v21
    v_mul_f32 v243, v243, v21
    v_mul_f32 v244, v244, v21
    v_mul_f32 v245, v245, v21
    v_mul_f32 v246, v246, v21
    v_mul_f32 v247, v247, v21
    v_cvt_pk_bf16_f32 v252, v240, v241
    v_cvt_pk_bf16_f32 v253, v242, v243
    v_cvt_pk_bf16_f32 v254, v244, v245
    v_cvt_pk_bf16_f32 v255, v246, v247
    ds_write_b128 v17, v[252:255] offset:25728
    s_waitcnt lgkmcnt(0)
    s_barrier
    s_add_u32 s6, s47, 3
    v_add_u32 v20, 0x200000, v4
    v_mov_b32 v242, s6
    v_mov_b32 v243, s7
    s_mov_b32 s48, 0
Lpoll_22:
    global_load_dwordx4 v[208:211], v20, s[42:43] offset:0 sc1
    global_load_dwordx4 v[212:215], v20, s[42:43] offset:1024 sc1
    global_load_dwordx4 v[216:219], v20, s[42:43] offset:2048 sc1
    global_load_dwordx4 v[220:223], v20, s[42:43] offset:3072 sc1
    s_add_u32 s48, s48, 1
    s_cmp_gt_u32 s48, 400000
    s_cbranch_scc1 L_end
    s_waitcnt vmcnt(3)
    v_xor_b32 v23, s6, v210
    v_xor_b32 v24, s7, v211
    v_or_b32 v25, v23, v24
    s_waitcnt vmcnt(2)
    v_xor_b32 v23, s6, v214
    v_xor_b32 v24, s7, v215
    v_or3_b32 v25, v23, v24, v25
    s_waitcnt vmcnt(1)
    v_xor_b32 v23, s6, v218
    v_xor_b32 v24, s7, v219
    v_or3_b32 v25, v23, v24, v25
    s_waitcnt vmcnt(0)
    v_xor_b32 v23, s6, v222
    v_xor_b32 v24, s7, v223
    v_or3_b32 v25, v23, v24, v25
    v_cmp_ne_u32 vcc, 0, v25
    s_cbranch_vccnz Lpoll_22
    v_add_f32 v240, v208, v212
    v_add_f32 v244, v216, v220
    v_add_f32 v241, v209, v213
    v_add_f32 v245, v217, v221
    v_add_f32 v240, v240, v244
    v_add_f32 v241, v241, v245
    s_nop 0
    v_add_f32_dpp v240, v240, v240 row_ror:8 row_mask:0xf bank_mask:0xf
    v_add_f32_dpp v241, v241, v241 row_ror:8 row_mask:0xf bank_mask:0xf
    v_mov_b32 v244, v240
    v_mov_b32 v245, v241
    s_nop 0
    v_permlane16_swap_b32 v240, v244
    v_permlane16_swap_b32 v241, v245
    s_nop 0
    v_add_f32 v240, v240, v244
    v_add_f32 v241, v241, v245
    v_mov_b32 v244, v240
    v_mov_b32 v245, v241
    s_nop 0
    v_permlane32_swap_b32 v240, v244
    v_permlane32_swap_b32 v241, v245
    s_nop 0
    v_add_f32 v240, v240, v244
    v_add_f32 v241, v241, v245
    v_add_u32 v20, s49, v27
    s_mov_b64 exec, 0xff
    global_store_dwordx4 v20, v[240:243], s[42:43] sc1
    s_mov_b64 exec, -1
    v_add_u32 v20, s49, v7
    s_add_u32 s49, s49, 0x8000
    s_mov_b32 s48, 0
Lpoll_23:
    global_load_dwordx4 v[208:211], v20, s[42:43] offset:0 sc1
    s_add_u32 s48, s48, 1
    s_cmp_gt_u32 s48, 400000
    s_cbranch_scc1 L_end
    s_waitcnt vmcnt(0)
    v_xor_b32 v23, s6, v210
    v_xor_b32 v24, s7, v211
    v_or_b32 v25, v23, v24
    v_cmp_ne_u32 vcc, 0, v25
    s_cbranch_vccnz Lpoll_23
    s_nop 0
    v_add_f32_dpp v208, v208, v208 row_ror:8 row_mask:0xf bank_mask:0xf
    v_add_f32_dpp v209, v209, v209 row_ror:8 row_mask:0xf bank_mask:0xf
    v_mov_b32 v244, v208
    v_mov_b32 v245, v209
    s_nop 0
    v_permlane16_swap_b32 v208, v244
    v_permlane16_swap_b32 v209, v245
    s_nop 0
    v_add_f32 v208, v208, v244
    v_add_f32 v209, v209, v245
    v_mov_b32 v244, v208
    v_mov_b32 v245, v209
    s_nop 0
    v_permlane32_swap_b32 v208, v244
    v_permlane32_swap_b32 v209, v245
    s_nop 0
    v_add_f32 v208, v208, v244
    v_add_f32 v209, v209, v245
    v_cvt_pk_bf16_f32 v21, v208, v209
    v_lshlrev_b32 v208, 16, v21
    v_and_b32 v209, 0xffff0000, v21
    v_add_f32 v208, v208, v13
    v_add_f32 v209, v209, v14
    v_cvt_pk_bf16_f32 v21, v208, v209
    v_lshlrev_b32 v208, 16, v21
    v_and_b32 v209, 0xffff0000, v21
    v_add_f32 v208, v208, v10
    v_add_f32 v209, v209, v11
    v_cvt_pk_bf16_f32 v240, v208, v209
    v_lshlrev_b32 v10, 16, v240
    v_and_b32 v11, 0xffff0000, v240
    s_cmp_eq_u32 s63, 1
    s_cbranch_scc1 L_final
    v_mov_b32_dpp v241, v240 quad_perm:[1,1,3,3] row_mask:0xf bank_mask:0xf
    s_mov_b64 exec, 0x55
    s_cmp_eq_u32 s44, 1
    s_cbranch_scc1 Lpf_24
    global_store_dwordx4 v6, v[240:243], s[42:43] sc1
    s_branch Lpe_25
Lpf_24:
    global_store_dwordx4 v6, v[240:243], s[42:43]
Lpe_25:
    s_mov_b64 exec, -1
    ds_read_b64_tr_b16 v[144:145], v9 offset:0
    ds_read_b64_tr_b16 v[146:147], v9 offset:128
    ds_read_b64_tr_b16 v[148:149], v9 offset:1024
    ds_read_b64_tr_b16 v[150:151], v9 offset:1152
    ds_read_b64_tr_b16 v[152:153], v9 offset:2048
    ds_read_b64_tr_b16 v[154:155], v9 offset:2176
    ds_read_b64_tr_b16 v[156:157], v9 offset:3072
    ds_read_b64_tr_b16 v[158:159], v9 offset:3200
    ds_read_b64_tr_b16 v[160:161], v9 offset:4096
    ds_read_b64_tr_b16 v[162:163], v9 offset:4224
    ds_read_b64_tr_b16 v[164:165], v9 offset:5120
    ds_read_b64_tr_b16 v[166:167], v9 offset:5248
    ds_read_b64_tr_b16 v[168:169], v9 offset:6144
    ds_read_b64_tr_b16 v[170:171], v9 offset:6272
    ds_read_b64_tr_b16 v[172:173], v9 offset:7168
    ds_read_b64_tr_b16 v[174:175], v9 offset:7296
    ds_read_b64_tr_b16 v[176:177], v9 offset:8192
    ds_read_b64_tr_b16 v[178:179], v9 offset:8320
    ds_read_b64_tr_b16 v[180:181], v9 offset:9216
    ds_read_b64_tr_b16 v[182:183], v9 offset:9344
    ds_read_b64_tr_b16 v[184:185], v9 offset:10240
    ds_read_b64_tr_b16 v[186:187], v9 offset:10368
    ds_read_b64_tr_b16 v[188:189], v9 offset:11264
    ds_read_b64_tr_b16 v[190:191], v9 offset:11392
    ds_read_b64_tr_b16 v[192:193], v9 offset:12288
    ds_read_b64_tr_b16 v[194:195], v9 offset:12416
    ds_read_b64_tr_b16 v[196:197], v9 offset:13312
    ds_read_b64_tr_b16 v[198:199], v9 offset:13440
    ds_read_b64_tr_b16 v[200:201], v9 offset:14336
    ds_read_b64_tr_b16 v[202:203], v9 offset:14464
    ds_read_b64_tr_b16 v[204:205], v9 offset:15360
    ds_read_b64_tr_b16 v[206:207], v9 offset:15488
    s_mov_b32 s48, 0
Lpoll_26:
    global_load_dwordx4 v[216:219], v8, s[42:43] offset:0 sc1
    global_load_dwordx4 v[220:223], v8, s[42:43] offset:16 sc1
    s_add_u32 s48, s48, 1
    s_cmp_gt_u32 s48, 400000
    s_cbranch_scc1 L_end
    s_waitcnt vmcnt(1)
    v_xor_b32 v23, s6, v218
    v_xor_b32 v24, s7, v219
    v_or_b32 v25, v23, v24
    s_waitcnt vmcnt(0)
    v_xor_b32 v23, s6, v222
    v_xor_b32 v24, s7, v223
    v_or3_b32 v25, v23, v24, v25
    v_cmp_ne_u32 vcc, 0, v25
    s_cbranch_vccnz Lpoll_26
    v_mov_b32 v28, v216
    v_mov_b32 v29, v217
    v_mov_b32 v30, v220
    v_mov_b32 v31, v221
    s_add_u32 s47, s47, 4
    s_add_u32 s63, s63, 1
    s_branch L_mloop
L_final:
    s_cmp_lg_u32 s3, 0
    s_cbranch_scc1 Lnoout_27
    s_lshl_b32 s9, s4, 5
    v_lshlrev_b32 v20, 2, v1
    v_add_u32 v20, s9, v20
    s_mov_b64 exec, 0xff
    global_store_dword v20, v240, s[36:37]
    s_mov_b64 exec, -1
    s_cmp_lg_u32 s4, 0
    s_cbranch_scc1 Lnoout_27
    s_add_u32 s9, s8, 1
    v_mov_b32 v21, s9
    v_mov_b32 v20, 0
    s_mov_b64 exec, 1
    global_store_dword v20, v21, s[40:41]
    s_mov_b64 exec, -1
Lnoout_27:
L_end:
    s_endpgm
.section .rodata,"a"
.p2align 6
.amdhsa_kernel interleave_layers__sliding_block_cached__dense_activation_gelu__decode_kernel
  .amdhsa_next_free_vgpr 256
  .amdhsa_next_free_sgpr 102
  .amdhsa_accum_offset 256
  .amdhsa_group_segment_fixed_size 0
  .amdhsa_kernarg_size 104
  .amdhsa_user_sgpr_count 2
  .amdhsa_user_sgpr_kernarg_segment_ptr 1
  .amdhsa_system_sgpr_workgroup_id_x 1
.end_amdhsa_kernel
```
